```python
import torch

def _softmax(x, axis=-1):
    return torch.softmax(x, dim=axis)
def _gelu(x):
    return torch.nn.functional.gelu(x, approximate="tanh")
def _silu(x):
    return torch.nn.functional.silu(x)
def _sigmoid(x):
    return torch.sigmoid(x)
def _layernorm(x, axis=-1, eps=1e-5):
    m = x.mean(dim=axis, keepdim=True)
    v = x.var(dim=axis, keepdim=True, unbiased=False)
    return (x - m) / torch.sqrt(v + eps)
def _scatter_add(tgt, idx, src, axis=0):
    return tgt.clone().index_add_(axis, idx, src)
def _segment_sum(src, seg, n):
    out = torch.zeros((n,) + src.shape[1:], dtype=src.dtype)
    return out.index_add_(0, seg, src)
def _pad(x, pw):
    flat = tuple(v for pair in reversed(pw) for v in pair)
    return torch.nn.functional.pad(x, flat)

kernel_name = 'standalone__se_block__vision'

def setup_inputs():

    _w = (lambda a: (lambda t: t.to(torch.bfloat16) if t.is_floating_point() else t)(torch.as_tensor(a)))
    H = W = 512
    C = 96; r = max(C // 16, 4)
    return {
        "x": _w((lambda *s: torch.randn(*s, dtype=torch.bfloat16) * 3.2)(1, H, W, C)),
        "w_down": _w((lambda *s: torch.randn(*s, dtype=torch.bfloat16) * 12.8)(C, r)),
        "w_up": _w((lambda *s: torch.randn(*s, dtype=torch.bfloat16) * 3.2)(r, C)),
    }

def reference(x, w_down, w_up):
    s = x.mean(axis=(1, 2))
    s = _sigmoid(_silu(s @ w_down) @ w_up)
    return x * s[:, None, None, :]
```

```asm
; @launch grid=(256,1,1) block=(512,1,1) lds=5120
.amdgcn_target "amdgcn-amd-amdhsa--gfx950"
.text
.globl standalone__se_block__vision_kernel
.p2align 12
.p2align 8
.type standalone__se_block__vision_kernel,@function
standalone__se_block__vision_kernel:
    s_load_dwordx2 s[16:17], s[0:1], 0
    s_load_dwordx2 s[24:25], s[0:1], 40
    v_lshrrev_b32 v20, 6, v0
    v_and_b32 v21, 15, v0
    v_readfirstlane_b32 s3, v20
    v_bfe_u32 v22, v0, 4, 2
    s_cmpk_ge_u32 s2, 256
    s_cbranch_scc1 L_exit
    v_mul_u32_u24 v1, 192, v22
    v_lshl_add_u32 v1, v21, 4, v1
    s_cmp_lt_u32 s3, 4
    s_cbranch_scc1 L_back1
    s_mov_b64 exec, 0
    s_cmp_eq_u32 s3, 4
    s_cbranch_scc1 L_padC
    s_cmp_eq_u32 s3, 5
    s_cbranch_scc1 L_padD
    s_cmp_eq_u32 s3, 6
    s_cbranch_scc1 L_padE
    s_branch L_padF
L_back1:
    s_lshl_b32 s41, s2, 5
    s_add_u32 s41, s41, s3
    s_mulk_i32 s41, 768
    s_mov_b32 s18, 50331648
    s_mov_b32 s19, 0x00020000
    s_movk_i32 s58, 6144
    s_mov_b32 s55, 6273024
    s_mov_b32 exec_lo, 0x0fff0fff
    s_mov_b32 s40, s41
    s_mov_b32 exec_hi, exec_lo
    s_lshr_b32 s42, s2, 4
    s_xor_b32 s43, s3, 3
    s_or_b32 s42, s42, s43
    s_waitcnt lgkmcnt(0)
    s_cbranch_scc0 L_zero
L_loads:
    buffer_load_dwordx4 v[76:79], v1, s[16:19], s40 offen nt
    s_add_u32 s40, s40, s58
    buffer_load_dwordx4 v[80:83], v1, s[16:19], s40 offen nt
    s_add_u32 s40, s40, s58
    buffer_load_dwordx4 v[84:87], v1, s[16:19], s40 offen nt
    s_add_u32 s40, s40, s58
    buffer_load_dwordx4 v[88:91], v1, s[16:19], s40 offen nt
    s_add_u32 s40, s40, s55
    buffer_load_dwordx4 v[92:95], v1, s[16:19], s40 offen nt
    s_add_u32 s40, s40, s58
    buffer_load_dwordx4 v[96:99], v1, s[16:19], s40 offen nt
    s_add_u32 s40, s40, s58
    buffer_load_dwordx4 v[100:103], v1, s[16:19], s40 offen nt
    s_add_u32 s40, s40, s58
    buffer_load_dwordx4 v[104:107], v1, s[16:19], s40 offen nt
    s_add_u32 s40, s40, s55
    buffer_load_dwordx4 v[108:111], v1, s[16:19], s40 offen nt
    s_add_u32 s40, s40, s58
    buffer_load_dwordx4 v[112:115], v1, s[16:19], s40 offen nt
    s_add_u32 s40, s40, s58
    buffer_load_dwordx4 v[116:119], v1, s[16:19], s40 offen nt
    s_add_u32 s40, s40, s58
    buffer_load_dwordx4 v[120:123], v1, s[16:19], s40 offen nt
    s_add_u32 s40, s40, s55
    s_branch L_setup
L_zero:
    s_setprio 3
    s_mov_b32 s26, 0x10000000
    s_mov_b32 s27, s19
    s_mov_b64 s[44:45], exec
    s_mov_b64 exec, -1
    v_and_b32 v10, 63, v0
    v_lshlrev_b32 v11, 4, v10
    v_mov_b64 v[52:53], 0
    v_mov_b64 v[54:55], 0
    s_lshl_b32 s43, s2, 10
    buffer_store_dwordx4 v[52:55], v11, s[24:27], s43 offen sc1
    s_cmp_lg_u32 s2, 0
    s_cbranch_scc1 L_zero2
    v_lshrrev_b32 v20, 3, v10
    v_lshlrev_b32 v20, 12, v20
    v_lshl_add_u32 v20, v10, 9, v20
    s_mov_b64 exec, 0xffff
    s_mov_b32 s43, 16384
    buffer_store_dwordx4 v[52:55], v20, s[24:27], s43 offen sc1
L_zero2:
    s_mov_b64 exec, -1
    s_load_dwordx2 s[28:29], s[0:1], 32
    s_movk_i32 s30, 256
    s_mov_b32 s31, s19
    s_movk_i32 s4, 0x100
    s_waitcnt vmcnt(0) lgkmcnt(0)
    s_cmp_lg_u32 s2, 0
    s_cbranch_scc1 L_flag2
    s_load_dword s14, s[24:25], 16384 glc
    s_waitcnt lgkmcnt(0)
    s_load_dword s12, s[24:25], 16384 glc
    s_load_dword s13, s[24:25], 16896 glc
    s_load_dword s14, s[24:25], 17408 glc
    s_load_dword s15, s[24:25], 17920 glc
    s_load_dword s12, s[24:25], 24576 glc
    s_load_dword s13, s[24:25], 25088 glc
    s_load_dword s14, s[24:25], 25600 glc
    s_load_dword s15, s[24:25], 26112 glc
    s_waitcnt lgkmcnt(4)
    s_memtime s[8:9]
    s_waitcnt lgkmcnt(0)
    s_memtime s[10:11]
    s_waitcnt lgkmcnt(0)
    s_sub_u32 s5, s10, s8
    s_load_dword s12, s[24:25], 26624 glc
    s_load_dword s13, s[24:25], 27136 glc
    s_load_dword s14, s[24:25], 27648 glc
    s_load_dword s15, s[24:25], 28160 glc
    s_load_dword s12, s[24:25], 18432 glc
    s_load_dword s13, s[24:25], 18944 glc
    s_load_dword s14, s[24:25], 19456 glc
    s_load_dword s15, s[24:25], 19968 glc
    s_waitcnt lgkmcnt(4)
    s_memtime s[8:9]
    s_waitcnt lgkmcnt(0)
    s_memtime s[10:11]
    s_waitcnt lgkmcnt(0)
    s_sub_u32 s4, s10, s8
    s_getreg_b32 s6, hwreg(HW_REG_XCC_ID, 0, 3)
    s_cmp_lt_u32 s4, s5
    s_cselect_b32 s4, 0, 4
    s_xor_b32 s4, s4, s6
    s_and_b32 s4, s4, 4
    s_lshl1_add_u32 s4, s4, s6
    s_lshl1_add_u32 s4, s4, 0x100
L_flag2:
    v_mov_b32 v24, s4
    s_mov_b64 exec, 1
    buffer_atomic_add v24, off, s[28:31], 0
    s_mov_b64 exec, s[44:45]
    s_branch L_loads
L_setup:
    s_load_dwordx2 s[20:21], s[0:1], 24
    s_load_dwordx2 s[28:29], s[0:1], 32
    s_mov_b32 s26, 0x10000000
    s_mov_b32 s27, s19
    s_movk_i32 s30, 256
    s_mov_b32 s31, s19
    s_mov_b64 s[44:45], exec
    s_mov_b64 exec, -1
    s_mov_b32 s22, s18
    s_mov_b32 s23, s19
    v_and_b32 v10, 63, v0
    v_and_b32 v20, 15, v0
    v_and_b32 v21, 1, v0
    v_lshlrev_b32 v21, 4, v21
    v_mov_b32 v22, 0x3f80
    v_lshlrev_b32 v21, v21, v22
    v_lshrrev_b32 v22, 1, v20
    v_cmp_eq_u32 vcc, 0, v22
    v_mov_b32 v6, 0
    s_nop 0
    v_cndmask_b32 v2, 0, v21, vcc
    v_cmp_eq_u32 vcc, 1, v22
    v_mov_b32 v7, 0
    s_nop 0
    v_cndmask_b32 v3, 0, v21, vcc
    v_cmp_eq_u32 vcc, 2, v22
    v_mov_b32 v8, 0
    s_nop 0
    v_cndmask_b32 v4, 0, v21, vcc
    v_cmp_eq_u32 vcc, 3, v22
    v_mov_b32 v9, 0
    s_nop 0
    v_cndmask_b32 v5, 0, v21, vcc
    v_bfe_u32 v23, v0, 4, 1
    v_lshlrev_b32 v23, 4, v23
    s_lshl_b32 s42, s3, 9
    s_addk_i32 s42, 1024
    v_add_u32 v23, s42, v23
    v_mul_u32_u24 v25, 43, v20
    v_lshrrev_b32 v25, 8, v25
    v_mul_u32_u24 v26, 6, v25
    v_sub_u32 v26, v20, v26
    v_lshl_add_u32 v16, v25, 8, v23
    v_lshl_add_u32 v16, v26, 5, v16
    v_lshlrev_b32 v26, 5, v20
    v_add_u32 v15, 512, v26
    v_lshlrev_b32 v14, 2, v10
    v_lshlrev_b32 v11, 4, v10
    v_lshrrev_b32 v24, 2, v10
    v_and_b32 v25, 3, v10
    v_mul_u32_u24 v17, 3, v24
    v_add_lshl_u32 v17, v17, v25, 2
    v_lshrrev_b32 v26, 4, v10
    v_lshlrev_b32 v18, 6, v26
    v_lshl_add_u32 v18, v25, 4, v18
    v_bfe_u32 v27, v10, 2, 1
    v_lshl_add_u32 v19, v27, 11, v18
    v_bfe_u32 v27, v10, 3, 1
    v_lshl_add_u32 v19, v27, 13, v19
    v_lshlrev_b32 v26, 8, v26
    v_lshl_add_u32 v12, v20, 2, v26
    s_cmp_eq_u32 s3, 0
    s_cbranch_scc1 L_ctl
    s_branch L_now
L_exit:
    s_endpgm
L_ctl:
    s_load_dwordx2 s[32:33], s[0:1], 8
    s_load_dwordx2 s[36:37], s[0:1], 16
    s_movk_i32 s34, 1152
    s_mov_b32 s35, s19
    s_movk_i32 s38, 1152
    s_mov_b32 s39, s19
    v_mov_b32 v31, 0
    v_mov_b64 v[32:33], 0
    v_mov_b64 v[34:35], 0
    v_mov_b64 v[36:37], 0
    v_mov_b64 v[38:39], 0
    v_mov_b64 v[40:41], 0
    v_mov_b64 v[42:43], 0
    v_mov_b64 v[44:45], 0
    v_mov_b64 v[46:47], 0
    v_mov_b64 v[48:49], 0
    v_mov_b64 v[50:51], 0
    v_and_b32 v21, 31, v0
    v_lshrrev_b32 v24, 5, v0
    v_mul_u32_u24 v28, 36, v21
    v_mad_u32_u24 v28, v24, 6, v28
    v_lshlrev_b32 v29, 1, v0
    s_waitcnt lgkmcnt(0)
    buffer_load_short_d16_hi v31, v28, s[32:35], 0 offen offset:0
    buffer_load_short_d16_hi v32, v28, s[32:35], 0 offen offset:2
    buffer_load_short_d16_hi v33, v28, s[32:35], 0 offen offset:4
    buffer_load_short_d16_hi v34, v28, s[32:35], 0 offen offset:12
    buffer_load_short_d16_hi v35, v28, s[32:35], 0 offen offset:14
    buffer_load_short_d16_hi v36, v28, s[32:35], 0 offen offset:16
    buffer_load_short_d16_hi v37, v28, s[32:35], 0 offen offset:24
    buffer_load_short_d16_hi v38, v28, s[32:35], 0 offen offset:26
    buffer_load_short_d16_hi v39, v28, s[32:35], 0 offen offset:28
    buffer_load_short_d16_hi v40, v29, s[36:39], 0 offen offset:0
    buffer_load_short_d16_hi v41, v29, s[36:39], 0 offen offset:128
    buffer_load_short_d16_hi v42, v29, s[36:39], 0 offen offset:192
    buffer_load_short_d16_hi v43, v29, s[36:39], 0 offen offset:320
    buffer_load_short_d16_hi v44, v29, s[36:39], 0 offen offset:384
    buffer_load_short_d16_hi v45, v29, s[36:39], 0 offen offset:512
    buffer_load_short_d16_hi v46, v29, s[36:39], 0 offen offset:576
    buffer_load_short_d16_hi v47, v29, s[36:39], 0 offen offset:704
    buffer_load_short_d16_hi v48, v29, s[36:39], 0 offen offset:768
    buffer_load_short_d16_hi v49, v29, s[36:39], 0 offen offset:896
    buffer_load_short_d16_hi v50, v29, s[36:39], 0 offen offset:960
    buffer_load_short_d16_hi v51, v29, s[36:39], 0 offen offset:1088
    s_mov_b32 s46, 0x88888888
    s_mov_b32 s47, s46
    s_mov_b32 s51, 0x42800000
    s_mov_b32 s50, 0x100000
L_now:
    s_mov_b64 exec, s[44:45]
    s_waitcnt vmcnt(11)
    buffer_load_dwordx4 v[124:127], v1, s[16:19], s40 offen nt
    s_add_u32 s40, s40, s58
    v_mfma_f32_16x16x32_bf16 v[6:9], v[2:5], v[76:79], v[6:9]
    s_waitcnt vmcnt(11)
    buffer_load_dwordx4 v[128:131], v1, s[16:19], s40 offen nt
    s_add_u32 s40, s40, s58
    v_mfma_f32_16x16x32_bf16 v[6:9], v[2:5], v[80:83], v[6:9]
    s_waitcnt vmcnt(11)
    buffer_load_dwordx4 v[132:135], v1, s[16:19], s40 offen nt
    s_add_u32 s40, s40, s58
    v_mfma_f32_16x16x32_bf16 v[6:9], v[2:5], v[84:87], v[6:9]
    s_waitcnt vmcnt(11)
    buffer_load_dwordx4 v[136:139], v1, s[16:19], s40 offen nt
    s_add_u32 s40, s40, s55
    v_mfma_f32_16x16x32_bf16 v[6:9], v[2:5], v[88:91], v[6:9]
    s_waitcnt vmcnt(11)
    buffer_load_dwordx4 v[140:143], v1, s[16:19], s40 offen nt
    s_add_u32 s40, s40, s58
    v_mfma_f32_16x16x32_bf16 v[6:9], v[2:5], v[92:95], v[6:9]
    s_waitcnt vmcnt(11)
    buffer_load_dwordx4 v[144:147], v1, s[16:19], s40 offen nt
    s_add_u32 s40, s40, s58
    v_mfma_f32_16x16x32_bf16 v[6:9], v[2:5], v[96:99], v[6:9]
    s_waitcnt vmcnt(11)
    buffer_load_dwordx4 v[148:151], v1, s[16:19], s40 offen nt
    s_add_u32 s40, s40, s58
    v_mfma_f32_16x16x32_bf16 v[6:9], v[2:5], v[100:103], v[6:9]
    s_waitcnt vmcnt(11)
    buffer_load_dwordx4 v[152:155], v1, s[16:19], s40 offen nt
    s_add_u32 s40, s40, s55
    v_mfma_f32_16x16x32_bf16 v[6:9], v[2:5], v[104:107], v[6:9]
    s_waitcnt vmcnt(11)
    buffer_load_dwordx4 v[156:159], v1, s[16:19], s40 offen nt
    s_add_u32 s40, s40, s58
    v_mfma_f32_16x16x32_bf16 v[6:9], v[2:5], v[108:111], v[6:9]
    s_waitcnt vmcnt(11)
    buffer_load_dwordx4 v[160:163], v1, s[16:19], s40 offen nt
    s_add_u32 s40, s40, s58
    v_mfma_f32_16x16x32_bf16 v[6:9], v[2:5], v[112:115], v[6:9]
    s_waitcnt vmcnt(11)
    buffer_load_dwordx4 v[164:167], v1, s[16:19], s40 offen nt
    s_add_u32 s40, s40, s58
    v_mfma_f32_16x16x32_bf16 v[6:9], v[2:5], v[116:119], v[6:9]
    s_waitcnt vmcnt(11)
    buffer_load_dwordx4 v[168:171], v1, s[16:19], s40 offen nt
    s_add_u32 s40, s40, s55
    v_mfma_f32_16x16x32_bf16 v[6:9], v[2:5], v[120:123], v[6:9]
    s_waitcnt vmcnt(11)
    buffer_load_dwordx4 v[172:175], v1, s[16:19], s40 offen nt
    s_add_u32 s40, s40, s58
    v_mfma_f32_16x16x32_bf16 v[6:9], v[2:5], v[124:127], v[6:9]
    s_waitcnt vmcnt(11)
    buffer_load_dwordx4 v[176:179], v1, s[16:19], s40 offen nt
    s_add_u32 s40, s40, s58
    v_mfma_f32_16x16x32_bf16 v[6:9], v[2:5], v[128:131], v[6:9]
    s_waitcnt vmcnt(11)
    buffer_load_dwordx4 v[180:183], v1, s[16:19], s40 offen nt
    s_add_u32 s40, s40, s58
    v_mfma_f32_16x16x32_bf16 v[6:9], v[2:5], v[132:135], v[6:9]
    s_waitcnt vmcnt(11)
    buffer_load_dwordx4 v[184:187], v1, s[16:19], s40 offen nt
    s_add_u32 s40, s40, s55
    v_mfma_f32_16x16x32_bf16 v[6:9], v[2:5], v[136:139], v[6:9]
    s_waitcnt vmcnt(11)
    buffer_load_dwordx4 v[188:191], v1, s[16:19], s40 offen nt
    s_add_u32 s40, s40, s58
    v_mfma_f32_16x16x32_bf16 v[6:9], v[2:5], v[140:143], v[6:9]
    s_waitcnt vmcnt(11)
    buffer_load_dwordx4 v[192:195], v1, s[16:19], s40 offen nt
    s_add_u32 s40, s40, s58
    v_mfma_f32_16x16x32_bf16 v[6:9], v[2:5], v[144:147], v[6:9]
    s_waitcnt vmcnt(11)
    buffer_load_dwordx4 v[196:199], v1, s[16:19], s40 offen nt
    s_add_u32 s40, s40, s58
    v_mfma_f32_16x16x32_bf16 v[6:9], v[2:5], v[148:151], v[6:9]
    s_waitcnt vmcnt(11)
    buffer_load_dwordx4 v[200:203], v1, s[16:19], s40 offen nt
    v_mfma_f32_16x16x32_bf16 v[6:9], v[2:5], v[152:155], v[6:9]
    s_cmp_lg_u32 s3, 0
    s_cbranch_scc1 L_nofl
    s_mov_b64 exec, 1
    buffer_load_dword v13, off, s[28:31], 0 sc1
L_nofl:
    s_mov_b64 exec, -1
    s_waitcnt vmcnt(11)
    v_mfma_f32_16x16x32_bf16 v[6:9], v[2:5], v[156:159], v[6:9]
    s_waitcnt vmcnt(10)
    v_mfma_f32_16x16x32_bf16 v[6:9], v[2:5], v[160:163], v[6:9]
    s_waitcnt vmcnt(9)
    v_mfma_f32_16x16x32_bf16 v[6:9], v[2:5], v[164:167], v[6:9]
    s_waitcnt vmcnt(8)
    v_mfma_f32_16x16x32_bf16 v[6:9], v[2:5], v[168:171], v[6:9]
    s_waitcnt vmcnt(7)
    v_mfma_f32_16x16x32_bf16 v[6:9], v[2:5], v[172:175], v[6:9]
    s_waitcnt vmcnt(6)
    v_mfma_f32_16x16x32_bf16 v[6:9], v[2:5], v[176:179], v[6:9]
    s_waitcnt vmcnt(5)
    v_mfma_f32_16x16x32_bf16 v[6:9], v[2:5], v[180:183], v[6:9]
    s_waitcnt vmcnt(4)
    v_mfma_f32_16x16x32_bf16 v[6:9], v[2:5], v[184:187], v[6:9]
    s_waitcnt vmcnt(3)
    v_mfma_f32_16x16x32_bf16 v[6:9], v[2:5], v[188:191], v[6:9]
    s_waitcnt vmcnt(2)
    v_mfma_f32_16x16x32_bf16 v[6:9], v[2:5], v[192:195], v[6:9]
    s_waitcnt vmcnt(1)
    v_mfma_f32_16x16x32_bf16 v[6:9], v[2:5], v[196:199], v[6:9]
    s_waitcnt vmcnt(0)
    v_mfma_f32_16x16x32_bf16 v[6:9], v[2:5], v[200:203], v[6:9]
    s_setprio 0
    s_mov_b32 exec_lo, 0x0fff0fff
    s_mov_b32 exec_hi, 0
    s_cmp_lg_u32 s3, 0
    s_nop 3
    ds_write_b128 v16, v[6:9]
    s_mov_b64 exec, -1
    s_cbranch_scc0 L_ctl2
    s_waitcnt lgkmcnt(0)
    s_barrier
    s_branch L_wait2
L_flagspin:
    buffer_load_dword v13, off, s[28:31], 0 sc1
    s_sub_u32 s50, s50, 1
    s_cbranch_scc1 L_flagok
    s_waitcnt vmcnt(0)
L_ctl2:
    v_readfirstlane_b32 s43, v13
    s_cmpk_lt_u32 s43, 0x1000
    s_cbranch_scc1 L_flagspin
L_flagok:
    s_getreg_b32 s54, hwreg(HW_REG_XCC_ID, 0, 3)
    s_lshr_b32 s42, s43, 1
    s_add_u32 s42, s42, s2
    s_lshr_b32 s43, s43, 2
    s_xor_b32 s42, s42, s43
    s_xor_b32 s52, s54, s43
    s_bfe_u32 s42, s42, 0x10002
    s_bfe_u32 s52, s52, 0x10002
    s_and_b32 s53, s54, 1
    s_bfe_u32 s43, s2, 0x10003
    s_lshl2_add_u32 s48, s42, s43
    s_lshl_b32 s48, s48, 11
    s_lshl1_add_u32 s56, s42, s43
    s_lshl_b32 s56, s56, 9
    s_addk_i32 s56, 4096
    s_lshl2_add_u32 s52, s52, s53
    s_lshl_b32 s52, s52, 11
    s_addk_i32 s52, 4096
    s_mov_b32 s43, 0x36800000
    v_mul_f32 v31, s43, v31
    v_mul_f32 v32, s43, v32
    v_mul_f32 v33, s43, v33
    v_mul_f32 v34, s43, v34
    v_mul_f32 v35, s43, v35
    v_mul_f32 v36, s43, v36
    v_mul_f32 v37, s43, v37
    v_mul_f32 v38, s43, v38
    v_mul_f32 v39, s43, v39
    s_mov_b32 s42, 0xbfb8aa3b
    s_waitcnt lgkmcnt(0)
    s_barrier
    ds_read2st64_b32 v[60:61], v17 offset0:4 offset1:5
    ds_read2st64_b32 v[62:63], v17 offset0:6 offset1:7
    ds_read2st64_b32 v[64:65], v17 offset0:8 offset1:9
    ds_read2st64_b32 v[66:67], v17 offset0:10 offset1:11
    ds_read2st64_b32 v[68:69], v17 offset0:12 offset1:13
    ds_read2st64_b32 v[70:71], v17 offset0:14 offset1:15
    ds_read2st64_b32 v[72:73], v17 offset0:16 offset1:17
    ds_read2st64_b32 v[74:75], v17 offset0:18 offset1:19
    s_waitcnt lgkmcnt(6)
    v_pk_add_f32 v[60:61], v[60:61], v[62:63]
    s_waitcnt lgkmcnt(4)
    v_pk_add_f32 v[64:65], v[64:65], v[66:67]
    s_waitcnt lgkmcnt(2)
    v_pk_add_f32 v[68:69], v[68:69], v[70:71]
    s_waitcnt lgkmcnt(0)
    v_pk_add_f32 v[72:73], v[72:73], v[74:75]
    v_pk_add_f32 v[60:61], v[60:61], v[64:65]
    v_pk_add_f32 v[68:69], v[68:69], v[72:73]
    v_pk_add_f32 v[22:23], v[60:61], v[68:69]
    v_cndmask_b32 v20, v22, 1.0, s[46:47]
    v_cndmask_b32 v21, v23, 1.0, s[46:47]
    buffer_atomic_add_f32 v20, v12, s[24:27], s48 offen sc0
    buffer_atomic_add_f32 v21, v12, s[24:27], s48 offen offset:1024 sc0
    v_cndmask_b32 v22, v22, 1.0, s[46:47]
    v_cndmask_b32 v23, v23, 1.0, s[46:47]
    s_waitcnt vmcnt(1)
    v_add_f32 v22, v22, v20
    s_waitcnt vmcnt(0)
    v_add_f32 v23, v23, v21
    ds_write2st64_b32 v14, v22, v23 offset0:0 offset1:1
    ds_read_b128 v[52:55], v18
    ds_read_b128 v[56:59], v18 offset:256
    s_waitcnt lgkmcnt(1)
    v_cmp_eq_f32 vcc, s51, v55
    s_and_b64 exec, vcc, vcc
    s_cbranch_scc0 L_nopubA
    buffer_store_dwordx4 v[52:55], v19, s[24:27], s56 offen sc1
L_nopubA:
    s_mov_b64 exec, -1
    s_waitcnt lgkmcnt(0)
    v_cmp_eq_f32 vcc, s51, v59
    s_and_b64 exec, vcc, vcc
    s_cbranch_scc0 L_nopubB
    buffer_store_dwordx4 v[56:59], v19, s[24:27], s56 offen offset:256 sc1
L_nopubB:
    s_mov_b64 exec, -1
L_poll:
    buffer_load_dwordx4 v[60:63], v11, s[24:27], s52 offen sc1
    buffer_load_dwordx4 v[64:67], v11, s[24:27], s52 offen offset:1024 sc1
    s_sub_u32 s50, s50, 1
    s_cbranch_scc1 L_done
    s_waitcnt vmcnt(1)
    v_cmp_eq_f32 vcc, s51, v63
    s_waitcnt vmcnt(0)
    v_cmp_eq_f32 s[4:5], s51, v67
    s_and_b64 vcc, vcc, s[4:5]
    s_cmp_eq_u64 vcc, -1
    s_cbranch_scc0 L_poll
L_done:
    v_pk_add_f32 v[52:53], v[60:61], v[64:65]
    v_pk_add_f32 v[56:57], v[60:61], v[64:65]
    v_add_f32 v54, v62, v66
    v_add_f32 v58, v62, v66
    v_permlane32_swap_b32 v56, v52
    v_permlane32_swap_b32 v57, v53
    v_permlane32_swap_b32 v58, v54
    v_pk_add_f32 v[52:53], v[52:53], v[56:57]
    v_add_f32 v54, v54, v58
    v_cvt_pk_bf16_f32 v52, 0, v52
    v_cvt_pk_bf16_f32 v53, 0, v53
    v_cvt_pk_bf16_f32 v54, 0, v54
    v_mul_f32 v56, v52, v31
    v_mul_f32 v57, v52, v32
    v_mul_f32 v58, v52, v33
    v_fmac_f32 v56, v53, v34
    v_fmac_f32 v57, v53, v35
    v_fmac_f32 v58, v53, v36
    v_fmac_f32 v56, v54, v37
    v_fmac_f32 v57, v54, v38
    v_fmac_f32 v58, v54, v39
    v_add_f32_dpp v56, v56, v56 quad_perm:[1,0,3,2] row_mask:0xf bank_mask:0xf
    v_add_f32_dpp v57, v57, v57 quad_perm:[1,0,3,2] row_mask:0xf bank_mask:0xf
    v_add_f32_dpp v58, v58, v58 quad_perm:[1,0,3,2] row_mask:0xf bank_mask:0xf
    v_add_f32_dpp v56, v56, v56 quad_perm:[2,3,0,1] row_mask:0xf bank_mask:0xf
    v_add_f32_dpp v57, v57, v57 quad_perm:[2,3,0,1] row_mask:0xf bank_mask:0xf
    v_add_f32_dpp v58, v58, v58 quad_perm:[2,3,0,1] row_mask:0xf bank_mask:0xf
    v_add_f32_dpp v56, v56, v56 row_half_mirror row_mask:0xf bank_mask:0xf
    v_add_f32_dpp v57, v57, v57 row_half_mirror row_mask:0xf bank_mask:0xf
    v_add_f32_dpp v58, v58, v58 row_half_mirror row_mask:0xf bank_mask:0xf
    v_add_f32_dpp v56, v56, v56 row_mirror row_mask:0xf bank_mask:0xf
    v_add_f32_dpp v57, v57, v57 row_mirror row_mask:0xf bank_mask:0xf
    v_add_f32_dpp v58, v58, v58 row_mirror row_mask:0xf bank_mask:0xf
    v_add_f32_dpp v52, v56, v56 row_bcast:15 row_mask:0xa bank_mask:0x1
    v_add_f32_dpp v52, v57, v57 row_bcast:15 row_mask:0xa bank_mask:0x2
    v_add_f32_dpp v52, v58, v58 row_bcast:15 row_mask:0xa bank_mask:0x4
    v_cvt_pk_bf16_f32 v56, 0, v52
    v_mul_f32 v52, s42, v56
    v_exp_f32 v52, v52
    s_nop 0
    v_add_f32 v52, 1.0, v52
    v_rcp_f32 v52, v52
    s_nop 0
    v_mul_f32 v56, v56, v52
    v_cvt_pk_bf16_f32 v56, 0, v56
    s_nop 0
    v_readlane_b32 s8, v56, 16
    v_readlane_b32 s9, v56, 20
    v_readlane_b32 s10, v56, 24
    v_readlane_b32 s11, v56, 48
    v_readlane_b32 s12, v56, 52
    v_readlane_b32 s13, v56, 56
    v_pk_mul_f32 v[52:53], v[40:41], s[8:9] op_sel:[0,0] op_sel_hi:[1,0]
    v_pk_fma_f32 v[52:53], v[42:43], s[8:9], v[52:53] op_sel:[0,1,0] op_sel_hi:[1,1,1]
    v_pk_fma_f32 v[52:53], v[44:45], s[10:11], v[52:53] op_sel:[0,0,0] op_sel_hi:[1,0,1]
    v_pk_fma_f32 v[52:53], v[46:47], s[10:11], v[52:53] op_sel:[0,1,0] op_sel_hi:[1,1,1]
    v_pk_fma_f32 v[52:53], v[48:49], s[12:13], v[52:53] op_sel:[0,0,0] op_sel_hi:[1,0,1]
    v_pk_fma_f32 v[52:53], v[50:51], s[12:13], v[52:53] op_sel:[0,1,0] op_sel_hi:[1,1,1]
    v_cvt_pk_bf16_f32 v52, 0, v52
    v_cvt_pk_bf16_f32 v53, 0, v53
    v_pk_mul_f32 v[52:53], v[52:53], s[42:43] op_sel:[0,0] op_sel_hi:[1,0]
    v_exp_f32 v52, v52
    v_exp_f32 v53, v53
    s_nop 0
    v_pk_add_f32 v[52:53], v[52:53], 1.0 op_sel_hi:[1,0]
    v_rcp_f32 v52, v52
    v_rcp_f32 v53, v53
    v_cvt_pk_bf16_f32 v52, 0, v52
    v_cvt_pk_bf16_f32 v53, 0, v53
    ds_write2st64_b32 v14, v52, v53 offset0:2 offset1:3
    s_waitcnt lgkmcnt(0)
    s_barrier
    s_cmp_lg_u32 s2, 0
    s_cbranch_scc1 L_go
    v_mov_b32 v20, 0
    s_mov_b64 exec, 1
    buffer_store_dword v20, off, s[28:31], 0 sc1
    s_mov_b64 exec, -1
    s_branch L_go
.p2align 12
L_wait2:
L_padC:
    s_cbranch_execz L_back1
    s_barrier
L_go:
    ds_read_b128 v[52:55], v15
    ds_read_b128 v[56:59], v15 offset:16
    s_mov_b64 exec, s[44:45]
    s_mov_b32 s40, s41
    s_mov_b32 s43, 0xffff0000
    v_lshlrev_b32 v20, 16, v76
    v_and_b32 v21, s43, v76
    v_lshlrev_b32 v22, 16, v77
    v_and_b32 v23, s43, v77
    v_lshlrev_b32 v24, 16, v78
    v_and_b32 v25, s43, v78
    v_lshlrev_b32 v26, 16, v79
    v_and_b32 v27, s43, v79
    s_waitcnt lgkmcnt(0)
    v_pk_mul_f32 v[20:21], v[20:21], v[52:53]
    v_pk_mul_f32 v[22:23], v[22:23], v[54:55]
    v_pk_mul_f32 v[24:25], v[24:25], v[56:57]
    v_pk_mul_f32 v[26:27], v[26:27], v[58:59]
    v_cvt_pk_bf16_f32 v76, v20, v21
    v_cvt_pk_bf16_f32 v77, v22, v23
    v_cvt_pk_bf16_f32 v78, v24, v25
    v_cvt_pk_bf16_f32 v79, v26, v27
    buffer_store_dwordx4 v[76:79], v1, s[20:23], s40 offen nt sc1
    s_add_u32 s40, s40, s58
    v_lshlrev_b32 v20, 16, v80
    v_and_b32 v21, s43, v80
    v_lshlrev_b32 v22, 16, v81
    v_and_b32 v23, s43, v81
    v_lshlrev_b32 v24, 16, v82
    v_and_b32 v25, s43, v82
    v_lshlrev_b32 v26, 16, v83
    v_and_b32 v27, s43, v83
    v_pk_mul_f32 v[20:21], v[20:21], v[52:53]
    v_pk_mul_f32 v[22:23], v[22:23], v[54:55]
    v_pk_mul_f32 v[24:25], v[24:25], v[56:57]
    v_pk_mul_f32 v[26:27], v[26:27], v[58:59]
    v_cvt_pk_bf16_f32 v80, v20, v21
    v_cvt_pk_bf16_f32 v81, v22, v23
    v_cvt_pk_bf16_f32 v82, v24, v25
    v_cvt_pk_bf16_f32 v83, v26, v27
    buffer_store_dwordx4 v[80:83], v1, s[20:23], s40 offen nt sc1
    s_add_u32 s40, s40, s58
    v_lshlrev_b32 v20, 16, v84
    v_and_b32 v21, s43, v84
    v_lshlrev_b32 v22, 16, v85
    v_and_b32 v23, s43, v85
    v_lshlrev_b32 v24, 16, v86
    v_and_b32 v25, s43, v86
    v_lshlrev_b32 v26, 16, v87
    v_and_b32 v27, s43, v87
    v_pk_mul_f32 v[20:21], v[20:21], v[52:53]
    v_pk_mul_f32 v[22:23], v[22:23], v[54:55]
    v_pk_mul_f32 v[24:25], v[24:25], v[56:57]
    v_pk_mul_f32 v[26:27], v[26:27], v[58:59]
    v_cvt_pk_bf16_f32 v84, v20, v21
    v_cvt_pk_bf16_f32 v85, v22, v23
    v_cvt_pk_bf16_f32 v86, v24, v25
    v_cvt_pk_bf16_f32 v87, v26, v27
    buffer_store_dwordx4 v[84:87], v1, s[20:23], s40 offen nt sc1
    s_add_u32 s40, s40, s58
    v_lshlrev_b32 v20, 16, v88
    v_and_b32 v21, s43, v88
    v_lshlrev_b32 v22, 16, v89
    v_and_b32 v23, s43, v89
    v_lshlrev_b32 v24, 16, v90
    v_and_b32 v25, s43, v90
    v_lshlrev_b32 v26, 16, v91
    v_and_b32 v27, s43, v91
    v_pk_mul_f32 v[20:21], v[20:21], v[52:53]
    v_pk_mul_f32 v[22:23], v[22:23], v[54:55]
    v_pk_mul_f32 v[24:25], v[24:25], v[56:57]
    v_pk_mul_f32 v[26:27], v[26:27], v[58:59]
    v_cvt_pk_bf16_f32 v88, v20, v21
    v_cvt_pk_bf16_f32 v89, v22, v23
    v_cvt_pk_bf16_f32 v90, v24, v25
    v_cvt_pk_bf16_f32 v91, v26, v27
    buffer_store_dwordx4 v[88:91], v1, s[20:23], s40 offen nt sc1
    s_add_u32 s40, s40, s55
    v_lshlrev_b32 v20, 16, v92
    v_and_b32 v21, s43, v92
    v_lshlrev_b32 v22, 16, v93
    v_and_b32 v23, s43, v93
    v_lshlrev_b32 v24, 16, v94
    v_and_b32 v25, s43, v94
    v_lshlrev_b32 v26, 16, v95
    v_and_b32 v27, s43, v95
    v_pk_mul_f32 v[20:21], v[20:21], v[52:53]
    v_pk_mul_f32 v[22:23], v[22:23], v[54:55]
    v_pk_mul_f32 v[24:25], v[24:25], v[56:57]
    v_pk_mul_f32 v[26:27], v[26:27], v[58:59]
    v_cvt_pk_bf16_f32 v92, v20, v21
    v_cvt_pk_bf16_f32 v93, v22, v23
    v_cvt_pk_bf16_f32 v94, v24, v25
    v_cvt_pk_bf16_f32 v95, v26, v27
    buffer_store_dwordx4 v[92:95], v1, s[20:23], s40 offen nt sc1
    s_add_u32 s40, s40, s58
    v_lshlrev_b32 v20, 16, v96
    v_and_b32 v21, s43, v96
    v_lshlrev_b32 v22, 16, v97
    v_and_b32 v23, s43, v97
    v_lshlrev_b32 v24, 16, v98
    v_and_b32 v25, s43, v98
    v_lshlrev_b32 v26, 16, v99
    v_and_b32 v27, s43, v99
    v_pk_mul_f32 v[20:21], v[20:21], v[52:53]
    v_pk_mul_f32 v[22:23], v[22:23], v[54:55]
    v_pk_mul_f32 v[24:25], v[24:25], v[56:57]
    v_pk_mul_f32 v[26:27], v[26:27], v[58:59]
    v_cvt_pk_bf16_f32 v96, v20, v21
    v_cvt_pk_bf16_f32 v97, v22, v23
    v_cvt_pk_bf16_f32 v98, v24, v25
    v_cvt_pk_bf16_f32 v99, v26, v27
    buffer_store_dwordx4 v[96:99], v1, s[20:23], s40 offen nt sc1
    s_add_u32 s40, s40, s58
    v_lshlrev_b32 v20, 16, v100
    v_and_b32 v21, s43, v100
    v_lshlrev_b32 v22, 16, v101
    v_and_b32 v23, s43, v101
    v_lshlrev_b32 v24, 16, v102
    v_and_b32 v25, s43, v102
    v_lshlrev_b32 v26, 16, v103
    v_and_b32 v27, s43, v103
    v_pk_mul_f32 v[20:21], v[20:21], v[52:53]
    v_pk_mul_f32 v[22:23], v[22:23], v[54:55]
    v_pk_mul_f32 v[24:25], v[24:25], v[56:57]
    v_pk_mul_f32 v[26:27], v[26:27], v[58:59]
    v_cvt_pk_bf16_f32 v100, v20, v21
    v_cvt_pk_bf16_f32 v101, v22, v23
    v_cvt_pk_bf16_f32 v102, v24, v25
    v_cvt_pk_bf16_f32 v103, v26, v27
    buffer_store_dwordx4 v[100:103], v1, s[20:23], s40 offen nt sc1
    s_add_u32 s40, s40, s58
    v_lshlrev_b32 v20, 16, v104
    v_and_b32 v21, s43, v104
    v_lshlrev_b32 v22, 16, v105
    v_and_b32 v23, s43, v105
    v_lshlrev_b32 v24, 16, v106
    v_and_b32 v25, s43, v106
    v_lshlrev_b32 v26, 16, v107
    v_and_b32 v27, s43, v107
    v_pk_mul_f32 v[20:21], v[20:21], v[52:53]
    v_pk_mul_f32 v[22:23], v[22:23], v[54:55]
    v_pk_mul_f32 v[24:25], v[24:25], v[56:57]
    v_pk_mul_f32 v[26:27], v[26:27], v[58:59]
    v_cvt_pk_bf16_f32 v104, v20, v21
    v_cvt_pk_bf16_f32 v105, v22, v23
    v_cvt_pk_bf16_f32 v106, v24, v25
    v_cvt_pk_bf16_f32 v107, v26, v27
    buffer_store_dwordx4 v[104:107], v1, s[20:23], s40 offen nt sc1
    s_add_u32 s40, s40, s55
    v_lshlrev_b32 v20, 16, v108
    v_and_b32 v21, s43, v108
    v_lshlrev_b32 v22, 16, v109
    v_and_b32 v23, s43, v109
    v_lshlrev_b32 v24, 16, v110
    v_and_b32 v25, s43, v110
    v_lshlrev_b32 v26, 16, v111
    v_and_b32 v27, s43, v111
    v_pk_mul_f32 v[20:21], v[20:21], v[52:53]
    v_pk_mul_f32 v[22:23], v[22:23], v[54:55]
    v_pk_mul_f32 v[24:25], v[24:25], v[56:57]
    v_pk_mul_f32 v[26:27], v[26:27], v[58:59]
    v_cvt_pk_bf16_f32 v108, v20, v21
    v_cvt_pk_bf16_f32 v109, v22, v23
    v_cvt_pk_bf16_f32 v110, v24, v25
    v_cvt_pk_bf16_f32 v111, v26, v27
    buffer_store_dwordx4 v[108:111], v1, s[20:23], s40 offen sc1
    s_add_u32 s40, s40, s58
L_padD:
    s_cbranch_execz L_back1
    v_lshlrev_b32 v20, 16, v112
    v_and_b32 v21, s43, v112
    v_lshlrev_b32 v22, 16, v113
    v_and_b32 v23, s43, v113
    v_lshlrev_b32 v24, 16, v114
    v_and_b32 v25, s43, v114
    v_lshlrev_b32 v26, 16, v115
    v_and_b32 v27, s43, v115
    v_pk_mul_f32 v[20:21], v[20:21], v[52:53]
    v_pk_mul_f32 v[22:23], v[22:23], v[54:55]
    v_pk_mul_f32 v[24:25], v[24:25], v[56:57]
    v_pk_mul_f32 v[26:27], v[26:27], v[58:59]
    v_cvt_pk_bf16_f32 v112, v20, v21
    v_cvt_pk_bf16_f32 v113, v22, v23
    v_cvt_pk_bf16_f32 v114, v24, v25
    v_cvt_pk_bf16_f32 v115, v26, v27
    buffer_store_dwordx4 v[112:115], v1, s[20:23], s40 offen sc1
    s_add_u32 s40, s40, s58
    v_lshlrev_b32 v20, 16, v116
    v_and_b32 v21, s43, v116
    v_lshlrev_b32 v22, 16, v117
    v_and_b32 v23, s43, v117
    v_lshlrev_b32 v24, 16, v118
    v_and_b32 v25, s43, v118
    v_lshlrev_b32 v26, 16, v119
    v_and_b32 v27, s43, v119
    v_pk_mul_f32 v[20:21], v[20:21], v[52:53]
    v_pk_mul_f32 v[22:23], v[22:23], v[54:55]
    v_pk_mul_f32 v[24:25], v[24:25], v[56:57]
    v_pk_mul_f32 v[26:27], v[26:27], v[58:59]
    v_cvt_pk_bf16_f32 v116, v20, v21
    v_cvt_pk_bf16_f32 v117, v22, v23
    v_cvt_pk_bf16_f32 v118, v24, v25
    v_cvt_pk_bf16_f32 v119, v26, v27
    buffer_store_dwordx4 v[116:119], v1, s[20:23], s40 offen sc1
    s_add_u32 s40, s40, s58
    v_lshlrev_b32 v20, 16, v120
    v_and_b32 v21, s43, v120
    v_lshlrev_b32 v22, 16, v121
    v_and_b32 v23, s43, v121
    v_lshlrev_b32 v24, 16, v122
    v_and_b32 v25, s43, v122
    v_lshlrev_b32 v26, 16, v123
    v_and_b32 v27, s43, v123
    v_pk_mul_f32 v[20:21], v[20:21], v[52:53]
    v_pk_mul_f32 v[22:23], v[22:23], v[54:55]
    v_pk_mul_f32 v[24:25], v[24:25], v[56:57]
    v_pk_mul_f32 v[26:27], v[26:27], v[58:59]
    v_cvt_pk_bf16_f32 v120, v20, v21
    v_cvt_pk_bf16_f32 v121, v22, v23
    v_cvt_pk_bf16_f32 v122, v24, v25
    v_cvt_pk_bf16_f32 v123, v26, v27
    buffer_store_dwordx4 v[120:123], v1, s[20:23], s40 offen sc1
    s_add_u32 s40, s40, s55
    v_lshlrev_b32 v20, 16, v124
    v_and_b32 v21, s43, v124
    v_lshlrev_b32 v22, 16, v125
    v_and_b32 v23, s43, v125
    v_lshlrev_b32 v24, 16, v126
    v_and_b32 v25, s43, v126
    v_lshlrev_b32 v26, 16, v127
    v_and_b32 v27, s43, v127
    v_pk_mul_f32 v[20:21], v[20:21], v[52:53]
    v_pk_mul_f32 v[22:23], v[22:23], v[54:55]
    v_pk_mul_f32 v[24:25], v[24:25], v[56:57]
    v_pk_mul_f32 v[26:27], v[26:27], v[58:59]
    v_cvt_pk_bf16_f32 v124, v20, v21
    v_cvt_pk_bf16_f32 v125, v22, v23
    v_cvt_pk_bf16_f32 v126, v24, v25
    v_cvt_pk_bf16_f32 v127, v26, v27
    buffer_store_dwordx4 v[124:127], v1, s[20:23], s40 offen sc1
    s_add_u32 s40, s40, s58
    v_lshlrev_b32 v20, 16, v128
    v_and_b32 v21, s43, v128
    v_lshlrev_b32 v22, 16, v129
    v_and_b32 v23, s43, v129
    v_lshlrev_b32 v24, 16, v130
    v_and_b32 v25, s43, v130
    v_lshlrev_b32 v26, 16, v131
    v_and_b32 v27, s43, v131
    v_pk_mul_f32 v[20:21], v[20:21], v[52:53]
    v_pk_mul_f32 v[22:23], v[22:23], v[54:55]
    v_pk_mul_f32 v[24:25], v[24:25], v[56:57]
    v_pk_mul_f32 v[26:27], v[26:27], v[58:59]
    v_cvt_pk_bf16_f32 v128, v20, v21
    v_cvt_pk_bf16_f32 v129, v22, v23
    v_cvt_pk_bf16_f32 v130, v24, v25
    v_cvt_pk_bf16_f32 v131, v26, v27
    buffer_store_dwordx4 v[128:131], v1, s[20:23], s40 offen sc1
    s_add_u32 s40, s40, s58
    v_lshlrev_b32 v20, 16, v132
    v_and_b32 v21, s43, v132
    v_lshlrev_b32 v22, 16, v133
    v_and_b32 v23, s43, v133
    v_lshlrev_b32 v24, 16, v134
    v_and_b32 v25, s43, v134
    v_lshlrev_b32 v26, 16, v135
    v_and_b32 v27, s43, v135
    v_pk_mul_f32 v[20:21], v[20:21], v[52:53]
    v_pk_mul_f32 v[22:23], v[22:23], v[54:55]
    v_pk_mul_f32 v[24:25], v[24:25], v[56:57]
    v_pk_mul_f32 v[26:27], v[26:27], v[58:59]
    v_cvt_pk_bf16_f32 v132, v20, v21
    v_cvt_pk_bf16_f32 v133, v22, v23
    v_cvt_pk_bf16_f32 v134, v24, v25
    v_cvt_pk_bf16_f32 v135, v26, v27
    buffer_store_dwordx4 v[132:135], v1, s[20:23], s40 offen sc1
    s_add_u32 s40, s40, s58
    v_lshlrev_b32 v20, 16, v136
    v_and_b32 v21, s43, v136
    v_lshlrev_b32 v22, 16, v137
    v_and_b32 v23, s43, v137
    v_lshlrev_b32 v24, 16, v138
    v_and_b32 v25, s43, v138
    v_lshlrev_b32 v26, 16, v139
    v_and_b32 v27, s43, v139
    v_pk_mul_f32 v[20:21], v[20:21], v[52:53]
    v_pk_mul_f32 v[22:23], v[22:23], v[54:55]
    v_pk_mul_f32 v[24:25], v[24:25], v[56:57]
    v_pk_mul_f32 v[26:27], v[26:27], v[58:59]
    v_cvt_pk_bf16_f32 v136, v20, v21
    v_cvt_pk_bf16_f32 v137, v22, v23
    v_cvt_pk_bf16_f32 v138, v24, v25
    v_cvt_pk_bf16_f32 v139, v26, v27
    buffer_store_dwordx4 v[136:139], v1, s[20:23], s40 offen sc1
    s_add_u32 s40, s40, s55
    v_lshlrev_b32 v20, 16, v140
    v_and_b32 v21, s43, v140
    v_lshlrev_b32 v22, 16, v141
    v_and_b32 v23, s43, v141
    v_lshlrev_b32 v24, 16, v142
    v_and_b32 v25, s43, v142
    v_lshlrev_b32 v26, 16, v143
    v_and_b32 v27, s43, v143
    v_pk_mul_f32 v[20:21], v[20:21], v[52:53]
    v_pk_mul_f32 v[22:23], v[22:23], v[54:55]
    v_pk_mul_f32 v[24:25], v[24:25], v[56:57]
    v_pk_mul_f32 v[26:27], v[26:27], v[58:59]
    v_cvt_pk_bf16_f32 v140, v20, v21
    v_cvt_pk_bf16_f32 v141, v22, v23
    v_cvt_pk_bf16_f32 v142, v24, v25
    v_cvt_pk_bf16_f32 v143, v26, v27
    buffer_store_dwordx4 v[140:143], v1, s[20:23], s40 offen sc1
    s_add_u32 s40, s40, s58
    v_lshlrev_b32 v20, 16, v144
    v_and_b32 v21, s43, v144
    v_lshlrev_b32 v22, 16, v145
    v_and_b32 v23, s43, v145
    v_lshlrev_b32 v24, 16, v146
    v_and_b32 v25, s43, v146
    v_lshlrev_b32 v26, 16, v147
    v_and_b32 v27, s43, v147
    v_pk_mul_f32 v[20:21], v[20:21], v[52:53]
    v_pk_mul_f32 v[22:23], v[22:23], v[54:55]
    v_pk_mul_f32 v[24:25], v[24:25], v[56:57]
    v_pk_mul_f32 v[26:27], v[26:27], v[58:59]
    v_cvt_pk_bf16_f32 v144, v20, v21
    v_cvt_pk_bf16_f32 v145, v22, v23
    v_cvt_pk_bf16_f32 v146, v24, v25
    v_cvt_pk_bf16_f32 v147, v26, v27
    buffer_store_dwordx4 v[144:147], v1, s[20:23], s40 offen nt
    s_add_u32 s40, s40, s58
L_padE:
    s_cbranch_execz L_back1
    v_lshlrev_b32 v20, 16, v148
    v_and_b32 v21, s43, v148
    v_lshlrev_b32 v22, 16, v149
    v_and_b32 v23, s43, v149
    v_lshlrev_b32 v24, 16, v150
    v_and_b32 v25, s43, v150
    v_lshlrev_b32 v26, 16, v151
    v_and_b32 v27, s43, v151
    v_pk_mul_f32 v[20:21], v[20:21], v[52:53]
    v_pk_mul_f32 v[22:23], v[22:23], v[54:55]
    v_pk_mul_f32 v[24:25], v[24:25], v[56:57]
    v_pk_mul_f32 v[26:27], v[26:27], v[58:59]
    v_cvt_pk_bf16_f32 v148, v20, v21
    v_cvt_pk_bf16_f32 v149, v22, v23
    v_cvt_pk_bf16_f32 v150, v24, v25
    v_cvt_pk_bf16_f32 v151, v26, v27
    buffer_store_dwordx4 v[148:151], v1, s[20:23], s40 offen nt
    s_add_u32 s40, s40, s58
    v_lshlrev_b32 v20, 16, v152
    v_and_b32 v21, s43, v152
    v_lshlrev_b32 v22, 16, v153
    v_and_b32 v23, s43, v153
    v_lshlrev_b32 v24, 16, v154
    v_and_b32 v25, s43, v154
    v_lshlrev_b32 v26, 16, v155
    v_and_b32 v27, s43, v155
    v_pk_mul_f32 v[20:21], v[20:21], v[52:53]
    v_pk_mul_f32 v[22:23], v[22:23], v[54:55]
    v_pk_mul_f32 v[24:25], v[24:25], v[56:57]
    v_pk_mul_f32 v[26:27], v[26:27], v[58:59]
    v_cvt_pk_bf16_f32 v152, v20, v21
    v_cvt_pk_bf16_f32 v153, v22, v23
    v_cvt_pk_bf16_f32 v154, v24, v25
    v_cvt_pk_bf16_f32 v155, v26, v27
    buffer_store_dwordx4 v[152:155], v1, s[20:23], s40 offen nt
    s_add_u32 s40, s40, s55
    v_lshlrev_b32 v20, 16, v156
    v_and_b32 v21, s43, v156
    v_lshlrev_b32 v22, 16, v157
    v_and_b32 v23, s43, v157
    v_lshlrev_b32 v24, 16, v158
    v_and_b32 v25, s43, v158
    v_lshlrev_b32 v26, 16, v159
    v_and_b32 v27, s43, v159
    v_pk_mul_f32 v[20:21], v[20:21], v[52:53]
    v_pk_mul_f32 v[22:23], v[22:23], v[54:55]
    v_pk_mul_f32 v[24:25], v[24:25], v[56:57]
    v_pk_mul_f32 v[26:27], v[26:27], v[58:59]
    v_cvt_pk_bf16_f32 v156, v20, v21
    v_cvt_pk_bf16_f32 v157, v22, v23
    v_cvt_pk_bf16_f32 v158, v24, v25
    v_cvt_pk_bf16_f32 v159, v26, v27
    buffer_store_dwordx4 v[156:159], v1, s[20:23], s40 offen nt
    s_add_u32 s40, s40, s58
    v_lshlrev_b32 v20, 16, v160
    v_and_b32 v21, s43, v160
    v_lshlrev_b32 v22, 16, v161
    v_and_b32 v23, s43, v161
    v_lshlrev_b32 v24, 16, v162
    v_and_b32 v25, s43, v162
    v_lshlrev_b32 v26, 16, v163
    v_and_b32 v27, s43, v163
    v_pk_mul_f32 v[20:21], v[20:21], v[52:53]
    v_pk_mul_f32 v[22:23], v[22:23], v[54:55]
    v_pk_mul_f32 v[24:25], v[24:25], v[56:57]
    v_pk_mul_f32 v[26:27], v[26:27], v[58:59]
    v_cvt_pk_bf16_f32 v160, v20, v21
    v_cvt_pk_bf16_f32 v161, v22, v23
    v_cvt_pk_bf16_f32 v162, v24, v25
    v_cvt_pk_bf16_f32 v163, v26, v27
    buffer_store_dwordx4 v[160:163], v1, s[20:23], s40 offen nt
    s_add_u32 s40, s40, s58
    v_lshlrev_b32 v20, 16, v164
    v_and_b32 v21, s43, v164
    v_lshlrev_b32 v22, 16, v165
    v_and_b32 v23, s43, v165
    v_lshlrev_b32 v24, 16, v166
    v_and_b32 v25, s43, v166
    v_lshlrev_b32 v26, 16, v167
    v_and_b32 v27, s43, v167
    v_pk_mul_f32 v[20:21], v[20:21], v[52:53]
    v_pk_mul_f32 v[22:23], v[22:23], v[54:55]
    v_pk_mul_f32 v[24:25], v[24:25], v[56:57]
    v_pk_mul_f32 v[26:27], v[26:27], v[58:59]
    v_cvt_pk_bf16_f32 v164, v20, v21
    v_cvt_pk_bf16_f32 v165, v22, v23
    v_cvt_pk_bf16_f32 v166, v24, v25
    v_cvt_pk_bf16_f32 v167, v26, v27
    buffer_store_dwordx4 v[164:167], v1, s[20:23], s40 offen nt
    s_add_u32 s40, s40, s58
    v_lshlrev_b32 v20, 16, v168
    v_and_b32 v21, s43, v168
    v_lshlrev_b32 v22, 16, v169
    v_and_b32 v23, s43, v169
    v_lshlrev_b32 v24, 16, v170
    v_and_b32 v25, s43, v170
    v_lshlrev_b32 v26, 16, v171
    v_and_b32 v27, s43, v171
    v_pk_mul_f32 v[20:21], v[20:21], v[52:53]
    v_pk_mul_f32 v[22:23], v[22:23], v[54:55]
    v_pk_mul_f32 v[24:25], v[24:25], v[56:57]
    v_pk_mul_f32 v[26:27], v[26:27], v[58:59]
    v_cvt_pk_bf16_f32 v168, v20, v21
    v_cvt_pk_bf16_f32 v169, v22, v23
    v_cvt_pk_bf16_f32 v170, v24, v25
    v_cvt_pk_bf16_f32 v171, v26, v27
    buffer_store_dwordx4 v[168:171], v1, s[20:23], s40 offen nt
    s_add_u32 s40, s40, s55
    v_lshlrev_b32 v20, 16, v172
    v_and_b32 v21, s43, v172
    v_lshlrev_b32 v22, 16, v173
    v_and_b32 v23, s43, v173
    v_lshlrev_b32 v24, 16, v174
    v_and_b32 v25, s43, v174
    v_lshlrev_b32 v26, 16, v175
    v_and_b32 v27, s43, v175
    v_pk_mul_f32 v[20:21], v[20:21], v[52:53]
    v_pk_mul_f32 v[22:23], v[22:23], v[54:55]
    v_pk_mul_f32 v[24:25], v[24:25], v[56:57]
    v_pk_mul_f32 v[26:27], v[26:27], v[58:59]
    v_cvt_pk_bf16_f32 v172, v20, v21
    v_cvt_pk_bf16_f32 v173, v22, v23
    v_cvt_pk_bf16_f32 v174, v24, v25
    v_cvt_pk_bf16_f32 v175, v26, v27
    buffer_store_dwordx4 v[172:175], v1, s[20:23], s40 offen nt
    s_add_u32 s40, s40, s58
    v_lshlrev_b32 v20, 16, v176
    v_and_b32 v21, s43, v176
    v_lshlrev_b32 v22, 16, v177
    v_and_b32 v23, s43, v177
    v_lshlrev_b32 v24, 16, v178
    v_and_b32 v25, s43, v178
    v_lshlrev_b32 v26, 16, v179
    v_and_b32 v27, s43, v179
    v_pk_mul_f32 v[20:21], v[20:21], v[52:53]
    v_pk_mul_f32 v[22:23], v[22:23], v[54:55]
    v_pk_mul_f32 v[24:25], v[24:25], v[56:57]
    v_pk_mul_f32 v[26:27], v[26:27], v[58:59]
    v_cvt_pk_bf16_f32 v176, v20, v21
    v_cvt_pk_bf16_f32 v177, v22, v23
    v_cvt_pk_bf16_f32 v178, v24, v25
    v_cvt_pk_bf16_f32 v179, v26, v27
    buffer_store_dwordx4 v[176:179], v1, s[20:23], s40 offen nt
    s_add_u32 s40, s40, s58
    v_lshlrev_b32 v20, 16, v180
    v_and_b32 v21, s43, v180
    v_lshlrev_b32 v22, 16, v181
    v_and_b32 v23, s43, v181
    v_lshlrev_b32 v24, 16, v182
    v_and_b32 v25, s43, v182
    v_lshlrev_b32 v26, 16, v183
    v_and_b32 v27, s43, v183
    v_pk_mul_f32 v[20:21], v[20:21], v[52:53]
    v_pk_mul_f32 v[22:23], v[22:23], v[54:55]
    v_pk_mul_f32 v[24:25], v[24:25], v[56:57]
    v_pk_mul_f32 v[26:27], v[26:27], v[58:59]
    v_cvt_pk_bf16_f32 v180, v20, v21
    v_cvt_pk_bf16_f32 v181, v22, v23
    v_cvt_pk_bf16_f32 v182, v24, v25
    v_cvt_pk_bf16_f32 v183, v26, v27
    buffer_store_dwordx4 v[180:183], v1, s[20:23], s40 offen nt
    s_add_u32 s40, s40, s58
L_padF:
    s_cbranch_execz L_back1
    v_lshlrev_b32 v20, 16, v184
    v_and_b32 v21, s43, v184
    v_lshlrev_b32 v22, 16, v185
    v_and_b32 v23, s43, v185
    v_lshlrev_b32 v24, 16, v186
    v_and_b32 v25, s43, v186
    v_lshlrev_b32 v26, 16, v187
    v_and_b32 v27, s43, v187
    v_pk_mul_f32 v[20:21], v[20:21], v[52:53]
    v_pk_mul_f32 v[22:23], v[22:23], v[54:55]
    v_pk_mul_f32 v[24:25], v[24:25], v[56:57]
    v_pk_mul_f32 v[26:27], v[26:27], v[58:59]
    v_cvt_pk_bf16_f32 v184, v20, v21
    v_cvt_pk_bf16_f32 v185, v22, v23
    v_cvt_pk_bf16_f32 v186, v24, v25
    v_cvt_pk_bf16_f32 v187, v26, v27
    buffer_store_dwordx4 v[184:187], v1, s[20:23], s40 offen nt
    s_add_u32 s40, s40, s55
    v_lshlrev_b32 v20, 16, v188
    v_and_b32 v21, s43, v188
    v_lshlrev_b32 v22, 16, v189
    v_and_b32 v23, s43, v189
    v_lshlrev_b32 v24, 16, v190
    v_and_b32 v25, s43, v190
    v_lshlrev_b32 v26, 16, v191
    v_and_b32 v27, s43, v191
    v_pk_mul_f32 v[20:21], v[20:21], v[52:53]
    v_pk_mul_f32 v[22:23], v[22:23], v[54:55]
    v_pk_mul_f32 v[24:25], v[24:25], v[56:57]
    v_pk_mul_f32 v[26:27], v[26:27], v[58:59]
    v_cvt_pk_bf16_f32 v188, v20, v21
    v_cvt_pk_bf16_f32 v189, v22, v23
    v_cvt_pk_bf16_f32 v190, v24, v25
    v_cvt_pk_bf16_f32 v191, v26, v27
    buffer_store_dwordx4 v[188:191], v1, s[20:23], s40 offen nt
    s_add_u32 s40, s40, s58
    v_lshlrev_b32 v20, 16, v192
    v_and_b32 v21, s43, v192
    v_lshlrev_b32 v22, 16, v193
    v_and_b32 v23, s43, v193
    v_lshlrev_b32 v24, 16, v194
    v_and_b32 v25, s43, v194
    v_lshlrev_b32 v26, 16, v195
    v_and_b32 v27, s43, v195
    v_pk_mul_f32 v[20:21], v[20:21], v[52:53]
    v_pk_mul_f32 v[22:23], v[22:23], v[54:55]
    v_pk_mul_f32 v[24:25], v[24:25], v[56:57]
    v_pk_mul_f32 v[26:27], v[26:27], v[58:59]
    v_cvt_pk_bf16_f32 v192, v20, v21
    v_cvt_pk_bf16_f32 v193, v22, v23
    v_cvt_pk_bf16_f32 v194, v24, v25
    v_cvt_pk_bf16_f32 v195, v26, v27
    buffer_store_dwordx4 v[192:195], v1, s[20:23], s40 offen nt
    s_add_u32 s40, s40, s58
    v_lshlrev_b32 v20, 16, v196
    v_and_b32 v21, s43, v196
    v_lshlrev_b32 v22, 16, v197
    v_and_b32 v23, s43, v197
    v_lshlrev_b32 v24, 16, v198
    v_and_b32 v25, s43, v198
    v_lshlrev_b32 v26, 16, v199
    v_and_b32 v27, s43, v199
    v_pk_mul_f32 v[20:21], v[20:21], v[52:53]
    v_pk_mul_f32 v[22:23], v[22:23], v[54:55]
    v_pk_mul_f32 v[24:25], v[24:25], v[56:57]
    v_pk_mul_f32 v[26:27], v[26:27], v[58:59]
    v_cvt_pk_bf16_f32 v196, v20, v21
    v_cvt_pk_bf16_f32 v197, v22, v23
    v_cvt_pk_bf16_f32 v198, v24, v25
    v_cvt_pk_bf16_f32 v199, v26, v27
    buffer_store_dwordx4 v[196:199], v1, s[20:23], s40 offen nt
    s_add_u32 s40, s40, s58
    v_lshlrev_b32 v20, 16, v200
    v_and_b32 v21, s43, v200
    v_lshlrev_b32 v22, 16, v201
    v_and_b32 v23, s43, v201
    v_lshlrev_b32 v24, 16, v202
    v_and_b32 v25, s43, v202
    v_lshlrev_b32 v26, 16, v203
    v_and_b32 v27, s43, v203
    v_pk_mul_f32 v[20:21], v[20:21], v[52:53]
    v_pk_mul_f32 v[22:23], v[22:23], v[54:55]
    v_pk_mul_f32 v[24:25], v[24:25], v[56:57]
    v_pk_mul_f32 v[26:27], v[26:27], v[58:59]
    v_cvt_pk_bf16_f32 v200, v20, v21
    v_cvt_pk_bf16_f32 v201, v22, v23
    v_cvt_pk_bf16_f32 v202, v24, v25
    v_cvt_pk_bf16_f32 v203, v26, v27
    buffer_store_dwordx4 v[200:203], v1, s[20:23], s40 offen nt
L_end:
    s_endpgm
.section .rodata,"a"
.p2align 6
.amdhsa_kernel standalone__se_block__vision_kernel
  .amdhsa_next_free_vgpr 204
  .amdhsa_next_free_sgpr 64
  .amdhsa_accum_offset 204
  .amdhsa_group_segment_fixed_size 0
  .amdhsa_kernarg_size 48
  .amdhsa_user_sgpr_count 2
  .amdhsa_user_sgpr_kernarg_segment_ptr 1
  .amdhsa_system_sgpr_workgroup_id_x 1
  .amdhsa_float_denorm_mode_32 3
.end_amdhsa_kernel
```
